```python
import torch

def _softmax(x, axis=-1):
    return torch.softmax(x, dim=axis)
def _gelu(x):
    return torch.nn.functional.gelu(x, approximate="tanh")
def _silu(x):
    return torch.nn.functional.silu(x)
def _sigmoid(x):
    return torch.sigmoid(x)
def _layernorm(x, axis=-1, eps=1e-5):
    m = x.mean(dim=axis, keepdim=True)
    v = x.var(dim=axis, keepdim=True, unbiased=False)
    return (x - m) / torch.sqrt(v + eps)
def _scatter_add(tgt, idx, src, axis=0):
    return tgt.clone().index_add_(axis, idx, src)
def _segment_sum(src, seg, n):
    out = torch.zeros((n,) + src.shape[1:], dtype=src.dtype)
    return out.index_add_(0, seg, src)
def _pad(x, pw):
    flat = tuple(v for pair in reversed(pw) for v in pair)
    return torch.nn.functional.pad(x, flat)

kernel_name = 'gated_mix__sliding_block_cached__swiglu_ffn__decode'

def setup_inputs():

    _w = (lambda a: (lambda t: t.to(torch.bfloat16) if t.is_floating_point() else t)(torch.as_tensor(a)))
    def _A_setup():
        B, Sq, D = 2, 1, 512
        Hq, Hkv, Sk, Dh = 32, 8, 16384, 128
        assert Hq % Hkv == 0, (Hq, Hkv)
        return {
            "x": _w((lambda *s: torch.randn(*s, dtype=torch.bfloat16) * 0.05)(B, Sq, D)),
            "k_cache": _w((lambda *s: torch.randn(*s, dtype=torch.bfloat16) * 6.4)(B, Hkv, Sk, Dh)),
            "v_cache": _w((lambda *s: torch.randn(*s, dtype=torch.bfloat16) * 0.4)(B, Hkv, Sk, Dh)),
            "wq": _w((lambda *s: torch.randn(*s, dtype=torch.bfloat16) * 6.4)(D, Hq * Dh) * (D ** -0.5)),
            "wo": _w((lambda *s: torch.randn(*s, dtype=torch.bfloat16) * 0.4)(Hq * Dh, D) * ((Hq * Dh) ** -0.5)),
        }
    _A_in = _A_setup()

    def _B_setup():
        B, S, D, F = 2, 1, 512, 1792
        return {
            "x": _w((lambda *s: torch.randn(*s, dtype=torch.bfloat16) * 0.05)(B, S, D)),
            "w_gate": _w((lambda *s: torch.randn(*s, dtype=torch.bfloat16) * 0.05)(D, F)),
            "w_up": _w((lambda *s: torch.randn(*s, dtype=torch.bfloat16) * 0.05)(D, F)),
            "w_down": _w((lambda *s: torch.randn(*s, dtype=torch.bfloat16) * 0.05)(F, D)),
        }
    _B_in = _B_setup()

    return {
        "A_x": _A_in["x"],
        "A_k_cache": _A_in["k_cache"],
        "A_v_cache": _A_in["v_cache"],
        "A_wq": _A_in["wq"],
        "A_wo": _A_in["wo"],
        "B_x": _B_in["x"],
        "B_w_gate": _B_in["w_gate"],
        "B_w_up": _B_in["w_up"],
        "B_w_down": _B_in["w_down"],
        "gate_w": _w((lambda *s: torch.randn(*s, dtype=torch.bfloat16) * 0.05)(512) * 16.0),
    }

def reference(A_x, A_k_cache, A_v_cache, A_wq, A_wo, B_x, B_w_gate, B_w_up, B_w_down, gate_w):
    def _A_ref(x, k_cache, v_cache, wq, wo):
        B, Sq, D = x.shape
        Hq, Dh = 32, 128
        Hkv, Sk = k_cache.shape[1], k_cache.shape[2]
        W = min(4096, max(256, Sk // 4))
        rep = Hq // Hkv
        q = (lambda x, *d: x.permute(*d))((x @ wq).reshape(B, Sq, Hq, Dh), 0, 2, 1, 3)
        k = (lambda x, n, axis: torch.repeat_interleave(x, n, dim=axis))(k_cache[:, :, Sk - W:, :], rep, axis=1)
        v = (lambda x, n, axis: torch.repeat_interleave(x, n, dim=axis))(v_cache[:, :, Sk - W:, :], rep, axis=1)
        scores = torch.einsum("bhqd,bhkd->bhqk", q, k) * (Dh ** -0.5)
        p = _softmax(scores, axis=-1)
        o = torch.einsum("bhqk,bhkd->bhqd", p, v)
        return (lambda x, *d: x.permute(*d))(o, 0, 2, 1, 3).reshape(B, Sq, Hq * Dh) @ wo

    def _B_ref(x, w_gate, w_up, w_down):
        g = _silu(x @ w_gate)
        u = x @ w_up
        return (g * u) @ w_down

    x = A_x
    g = _sigmoid((x * gate_w).sum(-1, keepdims=True))
    a = _A_ref(x, A_k_cache, A_v_cache, A_wq, A_wo)
    b = _B_ref(x, B_w_gate, B_w_up, B_w_down)
    return g * a + (1 - g) * b
```

```asm
; @launch grid=(256,1,1) block=(960,1,1) lds=155648
.amdgcn_target "amdgcn-amd-amdhsa--gfx950"
.text
.p2align 12
L_first:
L_att:
    s_sub_u32 s3, s3, 3
    s_setprio 1
    s_lshl_b32 s55, s3, 13
    v_xor_b32 v4, v1, v2
    v_lshlrev_b32 v3, 8, v2
    v_lshl_add_u32 v3, v4, 4, v3
    v_add_u32 v3, s55, v3
    v_xor_b32 v4, 64, v3
    v_xor_b32 v5, 0x80, v3
    v_xor_b32 v6, 0xc0, v3
    v_and_b32 v12, 3, v2
    v_mul_u32_u24 v13, 320, v12
    v_lshl_add_u32 v13, v1, 4, v13
    v_add_u32 v13, 131072, v13
    s_lshl_b32 s56, s3, 6
    s_add_u32 s56, s56, 132352
    v_mul_u32_u24 v7, 576, v12
    v_lshl_add_u32 v7, v1, 3, v7
    v_add_u32 v7, s56, v7
    v_lshl_add_u32 v12, v12, 2, v14
    v_lshrrev_b32 v9, 2, v2
    v_mul_u32_u24 v8, 576, v9
    v_lshl_add_u32 v8, v1, 4, v8
    v_add_u32 v8, 132352, v8
    v_lshl_add_u32 v10, v1, 3, v9
    v_lshlrev_b32 v10, 8, v10
    v_and_b32 v11, 1, v1
    v_lshl_add_u32 v9, v11, 2, v9
    v_xor_b32 v9, s3, v9
    v_lshl_add_u32 v10, v9, 5, v10
    v_and_b32 v9, 3, v2
    v_lshl_add_u32 v10, v9, 3, v10
    v_add_u32 v10, 65536, v10
    v_lshlrev_b32 v11, 14, v1
    v_lshl_add_u32 v11, v9, 2, v11
    v_lshrrev_b32 v72, 2, v2
    v_lshl_add_u32 v11, v72, 8, v11
    s_and_b32 s57, s5, 7
    s_lshl_b32 s57, s57, 4
    s_bfe_u32 s60, s5, 0x10003
    s_lshl_b32 s60, s60, 10
    s_add_u32 s57, s57, s60
    s_lshr_b32 s60, s5, 4
    s_lshl_b32 s60, s60, 7
    s_add_u32 s57, s57, s60
    s_lshl_b32 s60, s4, 16
    s_add_u32 s57, s57, s60
    s_lshl_b32 s60, s3, 11
    s_add_u32 s57, s57, s60
    s_add_u32 s57, s57, 393216
    s_lshl_b32 s56, s4, 5
    s_add_u32 s56, s56, s5
    s_lshl_b32 s56, s56, 6
    s_add_u32 s56, s56, 327680
    s_mov_b32 s58, 0x3db504f3
    s_mov_b32 s59, 0x3fb8aa3b
    v_lshlrev_b32 v9, 3, v9
    v_mov_b32 v80, 0xfffff000
    v_lshlrev_b32 v81, 4, v1
    v_lshl_add_u32 v82, v1, 2, v14
    v_mov_b32 v84, 0x3f803f80
    v_mov_b32 v85, v84
    v_mov_b32 v86, v84
    v_mov_b32 v87, v84
    s_lshl_b32 s61, s3, 1
    s_add_u32 s61, s61, 10
    s_branch L_sp1b
L_sp1:
    s_add_u32 s68, s68, 1
    s_cmp_gt_u32 s68, 4194304
    s_cbranch_scc1 L_abort
    s_sleep 2
L_sp1b:
    ds_read_b32 v72, v14 offset:32
    s_waitcnt lgkmcnt(0)
    v_cmp_gt_i32 vcc, s61, v72
    s_cbranch_vccnz L_sp1
    ds_read_b128 v[16:19], v3 offset:0
    ds_read_b128 v[20:23], v4 offset:0
    ds_read_b128 v[24:27], v5 offset:0
    ds_read_b128 v[28:31], v6 offset:0
    ds_read_b128 v[32:35], v3 offset:4096
    ds_read_b128 v[36:39], v4 offset:4096
    ds_read_b128 v[40:43], v5 offset:4096
    ds_read_b128 v[44:47], v6 offset:4096
    s_mov_b64 exec, 1
    ds_add_u32 v14, v15 offset:44
    s_mov_b64 exec, -1
    s_branch L_sp2b
L_sp2:
    s_add_u32 s68, s68, 1
    s_cmp_gt_u32 s68, 4194304
    s_cbranch_scc1 L_abort
    s_sleep 1
L_sp2b:
    ds_read_b32 v75, v14 offset:64
    ds_read_b32 v73, v14 offset:68
    s_waitcnt lgkmcnt(0)
    v_cmp_gt_i32 vcc, 1, v75
    s_cbranch_vccnz L_sp2
    ds_read_b128 v[48:51], v13 offset:0
    ds_read_b128 v[52:55], v13 offset:64
    ds_read_b128 v[56:59], v13 offset:128
    ds_read_b128 v[60:63], v13 offset:192
    v_readfirstlane_b32 s6, v75
    v_readfirstlane_b32 s52, v73
    v_alignbit_b32 v9, v73, v73, v9
    v_and_b32 v9, 0xfff, v9
    s_and_b32 s48, s52, 0xfff
    s_bfe_u32 s49, s52, 0xc0008
    s_bfe_u32 s50, s52, 0xc0010
    s_and_b32 s51, s52, 15
    s_lshl_b32 s51, s51, 8
    s_lshr_b32 s35, s52, 24
    s_or_b32 s51, s51, s35
    s_waitcnt lgkmcnt(3)
    v_mfma_f32_16x16x32_bf16 v[64:67], v[16:19], v[48:51], 0
    v_mfma_f32_16x16x32_bf16 v[68:71], v[32:35], v[48:51], 0
    s_waitcnt lgkmcnt(2)
    v_mfma_f32_16x16x32_bf16 v[64:67], v[20:23], v[52:55], v[64:67]
    v_mfma_f32_16x16x32_bf16 v[68:71], v[36:39], v[52:55], v[68:71]
    s_waitcnt lgkmcnt(1)
    v_mfma_f32_16x16x32_bf16 v[64:67], v[24:27], v[56:59], v[64:67]
    v_mfma_f32_16x16x32_bf16 v[68:71], v[40:43], v[56:59], v[68:71]
    s_waitcnt lgkmcnt(0)
    v_mfma_f32_16x16x32_bf16 v[64:67], v[28:31], v[60:63], v[64:67]
    v_mfma_f32_16x16x32_bf16 v[68:71], v[44:47], v[60:63], v[68:71]
    s_nop 6
    v_cvt_pk_bf16_f32 v72, v64, v65
    v_cvt_pk_bf16_f32 v73, v66, v67
    v_lshlrev_b32 v64, 16, v72
    v_and_b32 v65, 0xffff0000, v72
    v_lshlrev_b32 v66, 16, v73
    v_and_b32 v67, 0xffff0000, v73
    v_mul_f32 v64, s58, v64
    v_mul_f32 v65, s58, v65
    v_mul_f32 v66, s58, v66
    v_mul_f32 v67, s58, v67
    v_cvt_pk_bf16_f32 v72, v64, v65
    v_cvt_pk_bf16_f32 v73, v66, v67
    v_lshlrev_b32 v64, 16, v72
    v_and_b32 v65, 0xffff0000, v72
    v_lshlrev_b32 v66, 16, v73
    v_and_b32 v67, 0xffff0000, v73
    v_cvt_pk_bf16_f32 v72, v68, v69
    v_cvt_pk_bf16_f32 v73, v70, v71
    v_lshlrev_b32 v68, 16, v72
    v_and_b32 v69, 0xffff0000, v72
    v_lshlrev_b32 v70, 16, v73
    v_and_b32 v71, 0xffff0000, v73
    v_mul_f32 v68, s58, v68
    v_mul_f32 v69, s58, v69
    v_mul_f32 v70, s58, v70
    v_mul_f32 v71, s58, v71
    v_cvt_pk_bf16_f32 v72, v68, v69
    v_cvt_pk_bf16_f32 v73, v70, v71
    v_lshlrev_b32 v68, 16, v72
    v_and_b32 v69, 0xffff0000, v72
    v_lshlrev_b32 v70, 16, v73
    v_and_b32 v71, 0xffff0000, v73
    v_max3_f32 v74, v64, v65, v66
    v_max3_f32 v74, v74, v67, v68
    v_max3_f32 v74, v74, v69, v70
    v_max_f32 v74, v74, v71
    s_mov_b32 exec_lo, 0x000f000f
    s_mov_b32 exec_hi, 0x000f000f
    ds_max_f32 v12, v74 offset:0
    s_mov_b64 exec, 1
    ds_add_u32 v14, v15 offset:36
    s_mov_b64 exec, -1
    s_branch L_sp3b
L_sp3:
    s_add_u32 s68, s68, 1
    s_cmp_gt_u32 s68, 4194304
    s_cbranch_scc1 L_abort
L_sp3b:
    ds_read_b32 v72, v14 offset:36
    ds_read_b32 v74, v12 offset:0
    s_waitcnt lgkmcnt(0)
    v_cmp_gt_i32 vcc, 8, v72
    s_cbranch_vccnz L_sp3
    v_mul_f32 v74, 0xbfb8aa3b, v74
    v_fma_f32 v64, v64, s59, v74
    v_fma_f32 v65, v65, s59, v74
    v_fma_f32 v66, v66, s59, v74
    v_fma_f32 v67, v67, s59, v74
    v_fma_f32 v68, v68, s59, v74
    v_fma_f32 v69, v69, s59, v74
    v_fma_f32 v70, v70, s59, v74
    v_fma_f32 v71, v71, s59, v74
    v_exp_f32 v64, v64
    v_exp_f32 v65, v65
    v_exp_f32 v66, v66
    v_exp_f32 v67, v67
    v_exp_f32 v68, v68
    v_exp_f32 v69, v69
    v_exp_f32 v70, v70
    v_exp_f32 v71, v71
    v_cvt_pk_bf16_f32 v76, v64, v65
    v_cvt_pk_bf16_f32 v77, v66, v67
    v_cvt_pk_bf16_f32 v78, v68, v69
    v_cvt_pk_bf16_f32 v79, v70, v71
    s_mov_b32 exec_lo, 0x000f000f
    s_mov_b32 exec_hi, 0x000f000f
    ds_write2_b64 v7, v[76:77], v[78:79] offset0:0 offset1:4
    s_mov_b64 exec, 1
    ds_add_u32 v14, v15 offset:40
    s_mov_b64 exec, -1
    s_branch L_sp4b
L_sp4:
    s_add_u32 s68, s68, 1
    s_cmp_gt_u32 s68, 4194304
    s_cbranch_scc1 L_abort
L_sp4b:
    ds_read_b32 v72, v14 offset:40
    s_waitcnt lgkmcnt(0)
    v_cmp_gt_i32 vcc, 8, v72
    s_cbranch_vccnz L_sp4
    ds_read_b128 v[16:19], v8 offset:0
    ds_read_b128 v[20:23], v8 offset:64
    ds_read_b128 v[24:27], v8 offset:128
    ds_read_b128 v[28:31], v8 offset:192
    ds_read_b128 v[32:35], v8 offset:256
    ds_read_b128 v[36:39], v8 offset:320
    ds_read_b128 v[40:43], v8 offset:384
    ds_read_b128 v[44:47], v8 offset:448
    ds_read_b32 v72, v14 offset:32
    ds_read_b32 v73, v82 offset:0
    s_waitcnt lgkmcnt(0)
    s_cmp_eq_u32 s3, 0
    s_cbranch_scc0 L_att_pv
    v_mfma_f32_16x16x32_bf16 v[68:71], v[16:19], v[84:87], 0
    v_mfma_f32_16x16x32_bf16 v[68:71], v[20:23], v[84:87], v[68:71]
    v_mfma_f32_16x16x32_bf16 v[68:71], v[24:27], v[84:87], v[68:71]
    v_mfma_f32_16x16x32_bf16 v[68:71], v[28:31], v[84:87], v[68:71]
    v_mfma_f32_16x16x32_bf16 v[68:71], v[32:35], v[84:87], v[68:71]
    v_mfma_f32_16x16x32_bf16 v[68:71], v[36:39], v[84:87], v[68:71]
    v_mfma_f32_16x16x32_bf16 v[68:71], v[40:43], v[84:87], v[68:71]
    v_mfma_f32_16x16x32_bf16 v[68:71], v[44:47], v[84:87], v[68:71]
    v_and_or_b32 v76, v73, v80, s48
    v_mov_b32 v78, s50
    v_mov_b32 v79, s51
    s_nop 4
    v_and_or_b32 v77, v68, v80, s49
    s_mov_b32 exec_lo, 0x00010001
    s_mov_b32 exec_hi, 0x00010001
    s_cmp_eq_u32 s6, 2
    s_cbranch_scc1 L_att_sl
    buffer_store_dwordx4 v[76:79], v81, s[44:47], s56 offen sc1
    s_branch L_att_sd
L_att_sl:
    buffer_store_dwordx4 v[76:79], v81, s[44:47], s56 offen
L_att_sd:
    s_mov_b64 exec, -1
L_att_pv:
    s_branch L_sp5c
L_sp5:
    s_add_u32 s68, s68, 1
    s_cmp_gt_u32 s68, 4194304
    s_cbranch_scc1 L_abort
L_sp5b:
    ds_read_b32 v72, v14 offset:32
    s_waitcnt lgkmcnt(0)
L_sp5c:
    v_cmp_gt_i32 vcc, 36, v72
    s_cbranch_vccnz L_sp5
    ds_read_b64_tr_b16 v[88:89], v10 offset:0
    ds_read_b64_tr_b16 v[90:91], v10 offset:1024
    ds_read_b64_tr_b16 v[92:93], v10 offset:8192
    ds_read_b64_tr_b16 v[94:95], v10 offset:9216
    ds_read_b64_tr_b16 v[96:97], v10 offset:16384
    ds_read_b64_tr_b16 v[98:99], v10 offset:17408
    ds_read_b64_tr_b16 v[100:101], v10 offset:24576
    ds_read_b64_tr_b16 v[102:103], v10 offset:25600
    ds_read_b64_tr_b16 v[104:105], v10 offset:32768
    ds_read_b64_tr_b16 v[106:107], v10 offset:33792
    ds_read_b64_tr_b16 v[108:109], v10 offset:40960
    ds_read_b64_tr_b16 v[110:111], v10 offset:41984
    s_waitcnt lgkmcnt(10)
    v_mfma_f32_16x16x32_bf16 v[64:67], v[16:19], v[88:91], 0
    s_waitcnt lgkmcnt(8)
    v_mfma_f32_16x16x32_bf16 v[64:67], v[20:23], v[92:95], v[64:67]
    s_waitcnt lgkmcnt(6)
    v_mfma_f32_16x16x32_bf16 v[64:67], v[24:27], v[96:99], v[64:67]
    s_waitcnt lgkmcnt(4)
    v_mfma_f32_16x16x32_bf16 v[64:67], v[28:31], v[100:103], v[64:67]
    s_waitcnt lgkmcnt(2)
    v_mfma_f32_16x16x32_bf16 v[64:67], v[32:35], v[104:107], v[64:67]
    s_waitcnt lgkmcnt(0)
    v_mfma_f32_16x16x32_bf16 v[64:67], v[36:39], v[108:111], v[64:67]
    s_branch L_sp6c
L_sp6:
    s_add_u32 s68, s68, 1
    s_cmp_gt_u32 s68, 4194304
    s_cbranch_scc1 L_abort
L_sp6b:
    ds_read_b32 v72, v14 offset:32
    s_waitcnt lgkmcnt(0)
L_sp6c:
    v_cmp_gt_i32 vcc, 40, v72
    s_cbranch_vccnz L_sp6
    ds_read_b64_tr_b16 v[112:113], v10 offset:49152
    ds_read_b64_tr_b16 v[114:115], v10 offset:50176
    ds_read_b64_tr_b16 v[116:117], v10 offset:57344
    ds_read_b64_tr_b16 v[118:119], v10 offset:58368
    s_waitcnt lgkmcnt(2)
    v_mfma_f32_16x16x32_bf16 v[64:67], v[40:43], v[112:115], v[64:67]
    s_waitcnt lgkmcnt(0)
    v_mfma_f32_16x16x32_bf16 v[64:67], v[44:47], v[116:119], v[64:67]
    s_mov_b64 exec, 1
    ds_add_u32 v14, v15 offset:48
    s_mov_b64 exec, -1
    s_cmp_eq_u32 s6, 2
    s_nop 3
    v_and_or_b32 v64, v64, v80, v9
    s_cbranch_scc0 L_att_g
    buffer_store_dword v64, v11, s[44:47], s57 offen
    s_endpgm
L_att_g:
    buffer_store_dword v64, v11, s[44:47], s57 offen sc1
    s_endpgm
L_b_gate:
    s_lshl_b32 s56, s7, 12
    s_and_b32 s57, s53, 1
    s_lshl_b32 s57, s57, 7
    s_add_u32 s56, s56, s57
    s_add_u32 s56, s56, 196608
    v_lshrrev_b32 v13, 3, v0
    v_lshlrev_b32 v13, 8, v13
    v_and_b32 v7, 7, v0
    v_lshl_add_u32 v13, v7, 4, v13
    v_bfe_u32 v108, v0, 3, 1
    v_and_b32 v110, 1, v1
    v_lshlrev_b32 v110, 7, v110
    v_lshl_add_u32 v110, v108, 5, v110
    v_and_b32 v109, 3, v0
    v_lshl_add_u32 v110, v109, 3, v110
    v_lshrrev_b32 v109, 1, v1
    v_lshl_add_u32 v110, v109, 6, v110
    v_bfe_u32 v109, v0, 2, 1
    v_lshl_add_u32 v110, v109, 2, v110
    v_add_u32 v110, 134912, v110
    v_mov_b32 v4, 0
    v_mov_b32 v5, 0
    s_waitcnt vmcnt(0)
    v_dot2c_f32_bf16 v4, v116, v124
    v_dot2c_f32_bf16 v4, v117, v125
    v_dot2c_f32_bf16 v4, v118, v126
    v_dot2c_f32_bf16 v4, v119, v127
    v_dot2c_f32_bf16 v5, v120, v124
    v_dot2c_f32_bf16 v5, v121, v125
    v_dot2c_f32_bf16 v5, v122, v126
    v_dot2c_f32_bf16 v5, v123, v127
    s_nop 2
    v_permlane32_swap_b32 v4, v5
    v_add_f32 v4, v4, v5
    v_mov_b32 v5, v4
    s_nop 1
    v_permlane16_swap_b32 v4, v5
    v_add_f32 v4, v4, v5
    s_nop 1
    v_add_f32_dpp v4, v4, v4 row_ror:8 row_mask:0xf bank_mask:0xf
    s_nop 1
    v_add_f32_dpp v4, v4, v4 row_ror:4 row_mask:0xf bank_mask:0xf
    s_nop 1
    v_add_f32_dpp v4, v4, v4 row_ror:2 row_mask:0xf bank_mask:0xf
    s_nop 1
    v_add_f32_dpp v4, v4, v4 row_ror:1 row_mask:0xf bank_mask:0xf
    v_cvt_pk_bf16_f32 v4, v4, v4
    v_and_b32 v4, 0xffff0000, v4
    v_mul_f32 v4, 0xbfb8aa3b, v4
    v_exp_f32 v4, v4
    s_nop 0
    v_add_f32 v4, 1.0, v4
    v_rcp_f32 v4, v4
    s_nop 0
    v_cvt_pk_bf16_f32 v4, v4, v4
    v_and_b32 v4, 0xffff0000, v4
    v_sub_f32 v5, 1.0, v4
    v_cvt_pk_bf16_f32 v5, v5, v5
    v_and_b32 v5, 0xffff0000, v5
    v_lshrrev_b32 v6, 5, v0
    v_lshl_add_u32 v6, v6, 2, v14
    ds_write2_b32 v6, v4, v5 offset0:18 offset1:20
    ds_write_b32 v14, v15 offset:56
    v_lshl_add_u32 v6, v108, 2, v14
    ds_read_b32 v109, v6 offset:80
    s_waitcnt lgkmcnt(0)
    s_cmp_lt_u32 s5, s34
    s_cbranch_scc1 L_ab_gemv
    s_mov_b64 exec, 1
    ds_add_u32 v14, v15 offset:96
    s_mov_b64 exec, -1
    s_endpgm
L_b_slow:
    s_add_u32 s70, s70, 1
    s_cmp_lt_u32 s70, 6
    s_cbranch_scc1 L_b_poll
    s_mov_b32 exec_hi, 0
    buffer_store_dwordx4 v[112:115], v111, s[44:47], s71 offen sc1
    s_mov_b64 exec, -1
    v_mov_b32 v4, 0
    v_and_b32 v32, -8, v32
    v_or3_b32 v4, v4, v32, v33
    v_or3_b32 v4, v4, v34, v35
    v_and_b32 v36, -8, v36
    v_or3_b32 v4, v4, v36, v37
    v_or3_b32 v4, v4, v38, v39
    v_and_b32 v4, 0xff, v4
    v_cmp_ne_u32 vcc, 0, v4
    s_cbranch_vccnz L_b_poll
    s_branch L_b_ok
L_b_h:
    s_branch L_sp7c
L_sp7:
    s_add_u32 s68, s68, 1
    s_cmp_gt_u32 s68, 4194304
    s_cbranch_scc1 L_abort
    s_sleep 1
L_sp7b:
    ds_read_b32 v5, v14 offset:32
    s_waitcnt lgkmcnt(0)
L_sp7c:
    v_cmp_gt_i32 vcc, 11, v5
    s_cbranch_vccnz L_sp7
L_b_poll:
    s_add_u32 s68, s68, 1
    s_cmp_gt_u32 s68, 4194304
    s_cbranch_scc1 L_abort
    buffer_load_dwordx4 v[32:35], v13, s[44:47], s56 offen sc1
    buffer_load_dwordx4 v[36:39], v13, s[44:47], s56 offen offset:2048 sc1
    s_waitcnt vmcnt(0)
    v_xor_b32 v32, s48, v32
    v_xor_b32 v33, s49, v33
    v_xor_b32 v34, s50, v34
    v_xor_b32 v35, s51, v35
    v_or3_b32 v4, v32, v33, v34
    v_or_b32 v4, v4, v35
    v_xor_b32 v36, s48, v36
    v_xor_b32 v37, s49, v37
    v_xor_b32 v38, s50, v38
    v_xor_b32 v39, s51, v39
    v_or3_b32 v4, v4, v36, v37
    v_or3_b32 v4, v4, v38, v39
    v_and_b32 v4, 0xff, v4
    v_cmp_ne_u32 vcc, 0, v4
    s_cbranch_vccnz L_b_slow
L_b_ok:
    v_permlane32_swap_b32 v32, v33
    v_permlane32_swap_b32 v34, v35
    v_permlane32_swap_b32 v36, v37
    v_permlane32_swap_b32 v38, v39
    v_add_f32 v32, v32, v33
    v_add_f32 v34, v34, v35
    v_add_f32 v36, v36, v37
    v_add_f32 v38, v38, v39
    v_permlane16_swap_b32 v32, v34
    s_nop 0
    v_permlane16_swap_b32 v36, v38
    v_add_f32 v32, v32, v34
    v_add_f32 v36, v36, v38
    v_cvt_pk_bf16_f32 v32, v32, v36
    v_and_b32 v36, 0xffff0000, v32
    v_lshlrev_b32 v32, 16, v32
    v_mul_f32 v33, 0xbfb8aa3b, v32
    v_exp_f32 v33, v33
    v_mul_f32 v36, v36, v109
    v_add_f32 v33, 1.0, v33
    v_rcp_f32 v33, v33
    s_nop 0
    v_mul_f32 v32, v32, v33
    v_cvt_pk_bf16_f32 v32, v32, v32
    v_and_b32 v32, 0xffff0000, v32
    v_mul_f32 v32, v32, v36
    v_cvt_pk_bf16_f32 v32, v32, v32
    ds_write_b32 v110, v32
    ds_write_b32 v14, v15 offset:52
    s_waitcnt lgkmcnt(0)
    s_endpgm
L_a_slow:
    s_add_u32 s70, s70, 1
    s_cmp_lt_u32 s70, 6
    s_cbranch_scc1 L_a_poll
    s_mov_b32 exec_hi, 0
    buffer_store_dwordx4 v[112:115], v111, s[44:47], s71 offen sc1
    s_mov_b64 exec, -1
    v_mov_b32 v4, 0
    v_and_b32 v32, -8, v32
    v_or3_b32 v4, v4, v32, v33
    v_or3_b32 v4, v4, v34, v35
    v_and_b32 v36, -8, v36
    v_or3_b32 v4, v4, v36, v37
    v_or3_b32 v4, v4, v38, v39
    v_and_b32 v40, -8, v40
    v_or3_b32 v4, v4, v40, v41
    v_or3_b32 v4, v4, v42, v43
    v_and_b32 v44, -8, v44
    v_or3_b32 v4, v4, v44, v45
    v_or3_b32 v4, v4, v46, v47
    v_and_b32 v48, -8, v48
    v_or3_b32 v4, v4, v48, v49
    v_or3_b32 v4, v4, v50, v51
    v_and_b32 v52, -8, v52
    v_or3_b32 v4, v4, v52, v53
    v_or3_b32 v4, v4, v54, v55
    v_and_b32 v56, -8, v56
    v_or3_b32 v4, v4, v56, v57
    v_or3_b32 v4, v4, v58, v59
    v_and_b32 v60, -8, v60
    v_or3_b32 v4, v4, v60, v61
    v_or3_b32 v4, v4, v62, v63
    v_and_b32 v4, 0xff, v4
    v_cmp_ne_u32 vcc, 0, v4
    s_cbranch_vccnz L_a_poll
    v_mov_b32 v6, 1
    s_branch L_a_ok
L_a_cal:
    s_lshr_b32 s56, s2, 6
    s_lshl_b32 s56, s56, 14
    s_and_b32 s57, s2, 63
    s_lshl_b32 s57, s57, 7
    s_add_u32 s56, s56, s57
    s_add_u32 s56, s56, 1572864
    s_add_u32 s57, s56, 8192
    v_mov_b32 v3, 0
    s_mov_b64 exec, 1
    s_setprio 0
    s_branch L_sp8b
L_sp8:
    s_add_u32 s68, s68, 1
    s_cmp_gt_u32 s68, 4194304
    s_cbranch_scc1 L_abort
    s_sleep 8
L_sp8b:
    ds_read_b32 v5, v14 offset:32
    s_waitcnt lgkmcnt(0)
    v_cmp_gt_i32 vcc, 42, v5
    s_cbranch_vccnz L_sp8
    s_branch L_sp9b
L_sp9:
    s_add_u32 s68, s68, 1
    s_cmp_gt_u32 s68, 4194304
    s_cbranch_scc1 L_abort
L_sp9b:
    ds_read_b32 v5, v14 offset:104
    s_waitcnt lgkmcnt(0)
    v_cmp_gt_i32 vcc, 4, v5
    s_cbranch_vccnz L_sp9
    buffer_store_dword v3, v3, s[44:47], s56 offen sc1
    buffer_store_dword v3, v3, s[44:47], s57 offen sc1
    s_waitcnt vmcnt(1)
    s_memtime s[94:95]
    s_waitcnt vmcnt(0)
    s_memtime s[96:97]
    s_waitcnt lgkmcnt(0)
    s_sub_u32 s96, s96, s94
    s_cmp_gt_u32 s96, 64
    s_cselect_b32 s60, 1, 2
    v_mov_b32 v3, s60
    ds_write_b32 v14, v3 offset:108
    s_waitcnt lgkmcnt(0)
    s_endpgm
.fill (0xd00 - (. - L_first)) / 4, 4, 0xbf810000
.globl gated_mix__sliding_block_cached__swiglu_ffn__decode_kernel
.p2align 8
.type gated_mix__sliding_block_cached__swiglu_ffn__decode_kernel,@function
gated_mix__sliding_block_cached__swiglu_ffn__decode_kernel:
    s_load_dwordx16 s[8:23], s[0:1], 0
    s_load_dwordx8 s[24:31], s[0:1], 64
    s_load_dwordx2 s[32:33], s[0:1], 96
    s_cmp_ge_u32 s2, 256
    s_cbranch_scc1 L_exit
    v_lshrrev_b32 v1, 6, v0
    v_and_b32 v0, 63, v0
    s_and_b32 s4, s2, 7
    s_lshr_b32 s5, s2, 3
    v_readfirstlane_b32 s3, v1
    v_lshrrev_b32 v1, 4, v0
    v_and_b32 v2, 15, v0
    v_mov_b32 v14, 134656
    v_mov_b32 v15, 1
    s_mov_b32 s39, 0x20000
    s_mov_b32 s43, 0x20000
    s_mov_b32 s47, 0x20000
    s_mov_b32 s67, 0x20000
    s_mov_b32 s46, 2097152
    s_mov_b32 s68, 0
    s_lshl_b32 s53, s4, 2
    s_lshr_b32 s7, 0x43322110, s53
    s_and_b32 s7, s7, 15
    s_sub_u32 s7, s53, s7
    s_lshr_b32 s34, s5, 3
    s_add_u32 s7, s7, s34
    s_lshr_b32 s34, 0x43434343, s53
    s_and_b32 s34, s34, 15
    s_lshl_b32 s34, s34, 3
    s_and_b32 s54, s5, 3
    s_lshr_b32 s53, s5, 2
    s_cmp_eq_u32 s3, 0
    s_cbranch_scc1 L_loader
    s_cmp_eq_u32 s3, 3
    s_cbranch_scc0 L_rest1
    s_getpc_b64 s[60:61]
L_pc:
    s_sub_u32 s60, s60, L_pc-L_first
    s_subb_u32 s61, s61, 0
    v_lshlrev_b32 v3, 7, v0
    global_load_dword v122, v3, s[60:61]
    v_add_u32 v3, 0x2000, v3
    v_min_u32 v3, L_abort-L_first, v3
    s_mov_b32 exec_hi, 0
    global_load_dword v123, v3, s[60:61]
    s_mov_b64 exec, -1
L_rest1:
    s_waitcnt lgkmcnt(0)
    s_mov_b64 s[44:45], s[32:33]
    s_cmp_gt_u32 s3, 2
    s_cbranch_scc0 L_ab
    s_barrier
    s_cmp_lt_u32 s3, 11
    s_cbranch_scc1 L_att
    s_branch L_c_main
L_exit:
    s_endpgm
L_ab:
    s_load_dword s52, s[32:33], 0
    s_setprio 3
    s_mov_b64 s[64:65], s[8:9]
    s_mov_b32 s66, 2048
    s_lshl_b32 s59, s54, 8
    v_bfe_u32 v7, v2, 2, 1
    v_lshlrev_b32 v7, 10, v7
    v_lshl_add_u32 v7, v1, 4, v7
    v_lshlrev_b32 v13, 4, v0
    buffer_load_dwordx4 v[16:19], v7, s[64:67], s59 offen offset:0
    buffer_load_dwordx4 v[20:23], v7, s[64:67], s59 offen offset:64
    buffer_load_dwordx4 v[24:27], v7, s[64:67], s59 offen offset:128
    buffer_load_dwordx4 v[28:31], v7, s[64:67], s59 offen offset:192
    s_cmp_eq_u32 s3, 1
    s_cbranch_scc1 L_ab1
    s_mov_b64 s[40:41], s[26:27]
    s_mov_b32 s42, 1024
    buffer_load_dwordx4 v[116:119], v13, s[64:67], 0 offen
    buffer_load_dwordx4 v[120:123], v13, s[64:67], 0 offen offset:1024
    buffer_load_dwordx4 v[124:127], v13, s[40:43], 0 offen
L_ab1:
    s_barrier
    s_branch L_ab2
L_loader:
    s_setprio 2
    v_mov_b32 v8, 0xff800000
    v_cmp_gt_u32 vcc, 4, v0
    v_lshl_add_u32 v3, v0, 2, v14
    s_nop 0
    v_cndmask_b32 v4, 0, v8, vcc
    ds_write_b32 v3, v4
    v_lshrrev_b32 v10, 3, v0
    v_and_b32 v11, 1, v1
    v_lshlrev_b32 v11, 1, v11
    v_and_b32 v12, 7, v0
    v_xor_b32 v11, v11, v12
    v_lshlrev_b32 v11, 4, v11
    v_mul_u32_u24 v3, 8192, v10
    v_add_u32 v3, v3, v11
    v_xor_b32 v4, 64, v3
    v_add_u32 v4, 64512, v4
    v_add_u32 v5, 129024, v3
    v_add_u32 v6, 129024, v4
    s_lshl_b32 s56, s4, 3
    s_add_u32 s56, s56, s53
    s_xor_b32 s56, s56, 4
    s_lshl_b32 s57, s54, 13
    s_add_u32 s56, s56, s57
    s_lshl_b32 s56, s56, 7
    s_mov_b32 s38, 4194304
    s_mov_b32 m0, 139264
    s_waitcnt lgkmcnt(0)
    s_mov_b64 s[36:37], s[14:15]
L_ld10:
    buffer_load_dwordx4 v3, s[36:39], s56 offen offset:0 nt lds
    buffer_load_dwordx4 v4, s[36:39], s56 offen offset:1024 nt lds
    buffer_load_dwordx4 v5, s[36:39], s56 offen offset:2048 nt lds
    buffer_load_dwordx4 v6, s[36:39], s56 offen offset:3072 nt lds
    s_add_u32 s56, s56, 262144
    s_add_u32 m0, m0, 4096
    s_cmp_lt_u32 m0, 155648
    s_cbranch_scc1 L_ld10
    v_mul_u32_u24 v3, 3584, v10
    v_add_u32 v3, v3, v11
    v_xor_b32 v4, 64, v3
    v_add_u32 v4, 27648, v4
    v_add_u32 v5, 55296, v3
    v_add_u32 v6, 55296, v4
    s_mul_i32 s56, s54, 3584
    s_add_u32 s56, s56, s7
    s_lshl_b32 s56, s56, 7
    s_mov_b32 s38, 1835008
    s_mov_b32 m0, 114688
    s_bitcmp0_b32 s5, 2
    s_cselect_b64 s[36:37], s[20:21], s[22:23]
    s_cmp_lt_u32 s5, s34
    s_cselect_b32 s38, s38, 0
L_ld11:
    buffer_load_dwordx4 v3, s[36:39], s56 offen offset:0 nt lds
    buffer_load_dwordx4 v4, s[36:39], s56 offen offset:1024 nt lds
    buffer_load_dwordx4 v5, s[36:39], s56 offen offset:2048 nt lds
    buffer_load_dwordx4 v6, s[36:39], s56 offen offset:3072 nt lds
    s_add_u32 s56, s56, 114688
    s_add_u32 m0, m0, 4096
    s_cmp_lt_u32 m0, 131072
    s_cbranch_scc1 L_ld11
    s_lshr_b32 s60, s5, 4
    s_lshl_b32 s61, s60, 3
    s_add_u32 s61, s61, s4
    s_lshl_b32 s61, s61, 22
    s_and_b32 s57, s5, 15
    s_lshl_b32 s62, s57, 16
    s_add_u32 s61, s61, s62
    s_add_u32 s61, s61, 0x300000
    s_mul_i32 s55, s57, 4096
    v_xor_b32 v3, v1, v2
    v_lshlrev_b32 v3, 4, v3
    v_lshl_add_u32 v3, v1, 8, v3
    v_xor_b32 v4, 64, v3
    v_xor_b32 v5, 0x80, v3
    v_xor_b32 v6, 0xc0, v3
    s_mov_b32 s38, 67108864
    s_mov_b32 m0, 0
    s_mov_b64 s[36:37], s[10:11]
    s_and_b32 s55, s55, 0xffff
    s_add_u32 s56, s61, s55
    buffer_load_dwordx4 v3, s[36:39], s56 offen offset:0 nt lds
    buffer_load_dwordx4 v4, s[36:39], s56 offen offset:1024 nt lds
    buffer_load_dwordx4 v5, s[36:39], s56 offen offset:2048 nt lds
    buffer_load_dwordx4 v6, s[36:39], s56 offen offset:3072 nt lds
    s_add_u32 s55, s55, 4096
    s_add_u32 m0, m0, 4096
    s_waitcnt lgkmcnt(0)
    s_barrier
    v_mov_b32 v9, 0
L_ld13:
    s_and_b32 s55, s55, 0xffff
    s_add_u32 s56, s61, s55
    v_add_u32 v9, 1, v9
    s_waitcnt vmcnt(32)
    ds_write_b32 v14, v9 offset:32
    buffer_load_dwordx4 v3, s[36:39], s56 offen offset:0 nt lds
    buffer_load_dwordx4 v4, s[36:39], s56 offen offset:1024 nt lds
    buffer_load_dwordx4 v5, s[36:39], s56 offen offset:2048 nt lds
    buffer_load_dwordx4 v6, s[36:39], s56 offen offset:3072 nt lds
    s_add_u32 s55, s55, 4096
    s_add_u32 m0, m0, 4096
    s_cmp_lt_u32 m0, 65536
    s_cbranch_scc1 L_ld13
    v_lshlrev_b32 v3, 1, v1
    v_xor_b32 v3, v3, v2
    v_lshlrev_b32 v3, 4, v3
    v_lshl_add_u32 v3, v1, 8, v3
    v_mov_b32 v4, v3
    v_xor_b32 v5, 0x80, v3
    v_xor_b32 v6, 0x80, v3
    s_mov_b32 s38, 67108864
    s_mov_b32 m0, 65536
    s_mov_b64 s[36:37], s[12:13]
    v_mov_b32 v9, 15
L_ld14:
    s_and_b32 s55, s55, 0xffff
    s_add_u32 s56, s61, s55
    v_add_u32 v9, 1, v9
    s_waitcnt vmcnt(32)
    ds_write_b32 v14, v9 offset:32
    buffer_load_dwordx4 v3, s[36:39], s56 offen offset:0 nt lds
    buffer_load_dwordx4 v4, s[36:39], s56 offen offset:1024 nt lds
    buffer_load_dwordx4 v5, s[36:39], s56 offen offset:2048 nt lds
    buffer_load_dwordx4 v6, s[36:39], s56 offen offset:3072 nt lds
    s_add_u32 s55, s55, 4096
    s_add_u32 m0, m0, 4096
    s_cmp_lt_u32 m0, 114688
    s_cbranch_scc1 L_ld14
    s_branch L_sp15b
L_sp15:
    s_add_u32 s68, s68, 1
    s_cmp_gt_u32 s68, 4194304
    s_cbranch_scc1 L_abort
L_sp15b:
    ds_read_b32 v12, v14 offset:96
    s_waitcnt lgkmcnt(0)
    v_cmp_gt_i32 vcc, 2, v12
    s_cbranch_vccnz L_sp15
    v_mov_b32 v9, 27
L_ld16:
    s_and_b32 s55, s55, 0xffff
    s_add_u32 s56, s61, s55
    v_add_u32 v9, 1, v9
    s_waitcnt vmcnt(32)
    ds_write_b32 v14, v9 offset:32
    buffer_load_dwordx4 v3, s[36:39], s56 offen offset:0 nt lds
    buffer_load_dwordx4 v4, s[36:39], s56 offen offset:1024 nt lds
    buffer_load_dwordx4 v5, s[36:39], s56 offen offset:2048 nt lds
    buffer_load_dwordx4 v6, s[36:39], s56 offen offset:3072 nt lds
    s_add_u32 s55, s55, 4096
    s_add_u32 m0, m0, 4096
    s_cmp_lt_u32 m0, 131072
    s_cbranch_scc1 L_ld16
    v_lshlrev_b32 v3, 10, v1
    v_lshl_add_u32 v3, v2, 4, v3
    v_add_u32 v4, 15360, v3
    v_add_u32 v5, 30720, v3
    v_add_u32 v6, 46080, v3
    s_lshl_b32 s56, s7, 6
    s_and_b32 s57, s53, 1
    s_lshl_b32 s57, s57, 3
    s_add_u32 s56, s56, s57
    s_lshl_b32 s56, s56, 10
    s_lshl_b32 s57, s54, 8
    s_add_u32 s56, s56, s57
    s_mov_b32 s38, 1835008
    s_mov_b32 m0, 16384
    s_mov_b64 s[36:37], s[24:25]
    s_cmp_lt_u32 s5, s34
    s_cselect_b32 s38, s38, 0
    s_branch L_sp17b
L_sp17:
    s_add_u32 s68, s68, 1
    s_cmp_gt_u32 s68, 4194304
    s_cbranch_scc1 L_abort
L_sp17b:
    ds_read_b32 v12, v14 offset:44
    s_waitcnt lgkmcnt(0)
    v_cmp_gt_i32 vcc, 8, v12
    s_cbranch_vccnz L_sp17
    v_mov_b32 v9, 32
    s_waitcnt vmcnt(32)
    ds_write_b32 v14, v9 offset:32
    v_mov_b32 v9, 33
    s_waitcnt vmcnt(28)
    ds_write_b32 v14, v9 offset:32
    v_mov_b32 v9, 33
L_ld18:
    v_add_u32 v9, 1, v9
    s_waitcnt vmcnt(24)
    ds_write_b32 v14, v9 offset:32
    buffer_load_dwordx4 v3, s[36:39], s56 offen offset:0 nt lds
    buffer_load_dwordx4 v4, s[36:39], s56 offen offset:1024 nt lds
    buffer_load_dwordx4 v5, s[36:39], s56 offen offset:2048 nt lds
    buffer_load_dwordx4 v6, s[36:39], s56 offen offset:3072 nt lds
    s_add_u32 s56, s56, 4096
    s_add_u32 m0, m0, 4096
    s_cmp_lt_u32 m0, 24576
    s_cbranch_scc1 L_ld18
    v_lshlrev_b32 v3, 12, v1
    v_lshl_add_u32 v3, v2, 4, v3
    v_add_u32 v4, 15360, v3
    v_add_u32 v5, 30720, v3
    v_add_u32 v6, 46080, v3
    s_lshl_b32 s56, s4, 3
    s_add_u32 s56, s56, s53
    s_lshl_b32 s56, s56, 16
    s_lshl_b32 s57, s54, 8
    s_add_u32 s56, s56, s57
    s_mov_b32 s38, 4194304
    s_mov_b32 m0, 24576
    s_mov_b64 s[36:37], s[16:17]
    v_mov_b32 v9, 35
L_ld19:
    v_add_u32 v9, 1, v9
    s_waitcnt vmcnt(24)
    ds_write_b32 v14, v9 offset:32
    buffer_load_dwordx4 v3, s[36:39], s56 offen offset:0 nt lds
    buffer_load_dwordx4 v4, s[36:39], s56 offen offset:1024 nt lds
    buffer_load_dwordx4 v5, s[36:39], s56 offen offset:2048 nt lds
    buffer_load_dwordx4 v6, s[36:39], s56 offen offset:3072 nt lds
    s_add_u32 s56, s56, 1024
    s_add_u32 m0, m0, 4096
    s_cmp_lt_u32 m0, 40960
    s_cbranch_scc1 L_ld19
    v_mov_b32 v9, 40
    s_waitcnt vmcnt(24)
    ds_write_b32 v14, v9 offset:32
    v_mov_b32 v9, 41
    s_waitcnt vmcnt(20)
    ds_write_b32 v14, v9 offset:32
    v_mov_b32 v9, 42
    s_waitcnt vmcnt(16)
    ds_write_b32 v14, v9 offset:32
    v_mov_b32 v9, 43
    s_waitcnt vmcnt(12)
    ds_write_b32 v14, v9 offset:32
    v_mov_b32 v9, 44
    s_waitcnt vmcnt(8)
    ds_write_b32 v14, v9 offset:32
    v_mov_b32 v9, 45
    s_waitcnt vmcnt(4)
    ds_write_b32 v14, v9 offset:32
    v_mov_b32 v9, 46
    s_waitcnt vmcnt(0)
    ds_write_b32 v14, v9 offset:32
    s_waitcnt lgkmcnt(0)
    s_endpgm
L_ab2:
    s_cmp_eq_u32 s3, 1
    s_mov_b32 s55, 114688
    s_cselect_b32 s55, 139264, s55
    s_cselect_b32 s61, 1, 5
    v_lshrrev_b32 v8, 2, v2
    v_lshl_add_u32 v8, v1, 3, v8
    v_lshlrev_b32 v8, 7, v8
    v_and_b32 v9, 3, v2
    v_lshl_add_u32 v8, v9, 3, v8
    v_add_u32 v8, s55, v8
    v_lshrrev_b32 v9, 3, v2
    v_and_b32 v10, 1, v1
    v_lshl_add_u32 v9, v10, 1, v9
    v_lshl_add_u32 v8, v9, 5, v8
    v_xor_b32 v9, 32, v8
    v_xor_b32 v10, 64, v8
    v_xor_b32 v11, 0x60, v8
    v_mov_b32 v12, 0xffffff00
    s_lshl_b32 s56, s4, 14
    s_lshl_b32 s57, s54, 11
    s_add_u32 s56, s56, s57
    s_lshl_b32 s57, s53, 8
    s_add_u32 s56, s56, s57
    s_add_u32 s56, s56, 65536
    s_xor_b32 s56, s56, 1024
    s_lshl_b32 s57, s7, 12
    s_and_b32 s58, s5, 7
    s_lshl_b32 s58, s58, 9
    s_add_u32 s57, s57, s58
    s_add_u32 s57, s57, 196608
    s_cmp_eq_u32 s3, 1
    s_cselect_b32 s71, s56, s57
    s_cselect_b32 s57, 13, 8
    v_lshlrev_b32 v111, s57, v1
    v_lshl_add_u32 v111, v2, 4, v111
    s_getreg_b32 s60, hwreg(HW_REG_XCC_ID, 0, 3)
    s_mov_b32 s70, 0
    s_waitcnt lgkmcnt(0)
    s_add_u32 s52, s52, 0x01010108
    s_and_b32 s48, s52, 0xf8
    s_bfe_u32 s49, s52, 0x80008
    s_bfe_u32 s50, s52, 0x80010
    s_lshr_b32 s51, s52, 24
    s_or_b32 s48, s48, s60
    s_cmp_eq_u32 s3, 1
    s_cbranch_scc0 L_b_gate
L_ab_gemv:
    v_mov_b32 v5, -1
    s_waitcnt vmcnt(0)
    s_branch L_sp20c
L_sp20:
    s_add_u32 s68, s68, 1
    s_cmp_gt_u32 s68, 4194304
    s_cbranch_scc1 L_abort
    s_sleep 1
L_sp20b:
    ds_read_b32 v5, v14 offset:32
    s_waitcnt lgkmcnt(0)
L_sp20c:
    v_cmp_gt_i32 vcc, s61, v5
    s_cbranch_vccnz L_sp20
    ds_read_b64_tr_b16 v[32:33], v8 offset:0
    ds_read_b64_tr_b16 v[34:35], v8 offset:512
    ds_read_b64_tr_b16 v[36:37], v9 offset:0
    ds_read_b64_tr_b16 v[38:39], v9 offset:512
    ds_read_b64_tr_b16 v[40:41], v10 offset:0
    ds_read_b64_tr_b16 v[42:43], v10 offset:512
    ds_read_b64_tr_b16 v[44:45], v11 offset:0
    ds_read_b64_tr_b16 v[46:47], v11 offset:512
    s_add_u32 s61, s61, 1
    s_waitcnt lgkmcnt(6)
    v_mfma_f32_16x16x32_bf16 v[92:95], v[16:19], v[32:35], 0
    s_waitcnt lgkmcnt(4)
    v_mfma_f32_16x16x32_bf16 v[96:99], v[16:19], v[36:39], 0
    s_waitcnt lgkmcnt(2)
    v_mfma_f32_16x16x32_bf16 v[100:103], v[16:19], v[40:43], 0
    s_waitcnt lgkmcnt(0)
    v_mfma_f32_16x16x32_bf16 v[104:107], v[16:19], v[44:47], 0
    s_branch L_sp21c
L_sp21:
    s_add_u32 s68, s68, 1
    s_cmp_gt_u32 s68, 4194304
    s_cbranch_scc1 L_abort
L_sp21b:
    ds_read_b32 v5, v14 offset:32
    s_waitcnt lgkmcnt(0)
L_sp21c:
    v_cmp_gt_i32 vcc, s61, v5
    s_cbranch_vccnz L_sp21
    ds_read_b64_tr_b16 v[48:49], v8 offset:4096
    ds_read_b64_tr_b16 v[50:51], v8 offset:4608
    ds_read_b64_tr_b16 v[52:53], v9 offset:4096
    ds_read_b64_tr_b16 v[54:55], v9 offset:4608
    ds_read_b64_tr_b16 v[56:57], v10 offset:4096
    ds_read_b64_tr_b16 v[58:59], v10 offset:4608
    ds_read_b64_tr_b16 v[60:61], v11 offset:4096
    ds_read_b64_tr_b16 v[62:63], v11 offset:4608
    s_add_u32 s61, s61, 1
    s_waitcnt lgkmcnt(6)
    v_mfma_f32_16x16x32_bf16 v[92:95], v[20:23], v[48:51], v[92:95]
    s_waitcnt lgkmcnt(4)
    v_mfma_f32_16x16x32_bf16 v[96:99], v[20:23], v[52:55], v[96:99]
    s_waitcnt lgkmcnt(2)
    v_mfma_f32_16x16x32_bf16 v[100:103], v[20:23], v[56:59], v[100:103]
    s_waitcnt lgkmcnt(0)
    v_mfma_f32_16x16x32_bf16 v[104:107], v[20:23], v[60:63], v[104:107]
    s_branch L_sp22c
L_sp22:
    s_add_u32 s68, s68, 1
    s_cmp_gt_u32 s68, 4194304
    s_cbranch_scc1 L_abort
L_sp22b:
    ds_read_b32 v5, v14 offset:32
    s_waitcnt lgkmcnt(0)
L_sp22c:
    v_cmp_gt_i32 vcc, s61, v5
    s_cbranch_vccnz L_sp22
    ds_read_b64_tr_b16 v[32:33], v8 offset:8192
    ds_read_b64_tr_b16 v[34:35], v8 offset:8704
    ds_read_b64_tr_b16 v[36:37], v9 offset:8192
    ds_read_b64_tr_b16 v[38:39], v9 offset:8704
    ds_read_b64_tr_b16 v[40:41], v10 offset:8192
    ds_read_b64_tr_b16 v[42:43], v10 offset:8704
    ds_read_b64_tr_b16 v[44:45], v11 offset:8192
    ds_read_b64_tr_b16 v[46:47], v11 offset:8704
    s_add_u32 s61, s61, 1
    s_waitcnt lgkmcnt(6)
    v_mfma_f32_16x16x32_bf16 v[92:95], v[24:27], v[32:35], v[92:95]
    s_waitcnt lgkmcnt(4)
    v_mfma_f32_16x16x32_bf16 v[96:99], v[24:27], v[36:39], v[96:99]
    s_waitcnt lgkmcnt(2)
    v_mfma_f32_16x16x32_bf16 v[100:103], v[24:27], v[40:43], v[100:103]
    s_waitcnt lgkmcnt(0)
    v_mfma_f32_16x16x32_bf16 v[104:107], v[24:27], v[44:47], v[104:107]
    s_branch L_sp23c
L_sp23:
    s_add_u32 s68, s68, 1
    s_cmp_gt_u32 s68, 4194304
    s_cbranch_scc1 L_abort
L_sp23b:
    ds_read_b32 v5, v14 offset:32
    s_waitcnt lgkmcnt(0)
L_sp23c:
    v_cmp_gt_i32 vcc, s61, v5
    s_cbranch_vccnz L_sp23
    ds_read_b64_tr_b16 v[48:49], v8 offset:12288
    ds_read_b64_tr_b16 v[50:51], v8 offset:12800
    ds_read_b64_tr_b16 v[52:53], v9 offset:12288
    ds_read_b64_tr_b16 v[54:55], v9 offset:12800
    ds_read_b64_tr_b16 v[56:57], v10 offset:12288
    ds_read_b64_tr_b16 v[58:59], v10 offset:12800
    ds_read_b64_tr_b16 v[60:61], v11 offset:12288
    ds_read_b64_tr_b16 v[62:63], v11 offset:12800
    s_add_u32 s61, s61, 1
    s_waitcnt lgkmcnt(6)
    v_mfma_f32_16x16x32_bf16 v[92:95], v[28:31], v[48:51], v[92:95]
    s_waitcnt lgkmcnt(4)
    v_mfma_f32_16x16x32_bf16 v[96:99], v[28:31], v[52:55], v[96:99]
    s_waitcnt lgkmcnt(2)
    v_mfma_f32_16x16x32_bf16 v[100:103], v[28:31], v[56:59], v[100:103]
    s_waitcnt lgkmcnt(0)
    v_mfma_f32_16x16x32_bf16 v[104:107], v[28:31], v[60:63], v[104:107]
    s_mov_b64 exec, 1
    ds_add_u32 v14, v15 offset:96
    s_mov_b64 exec, -1
    v_add_u32 v112, 0x80, v92
    v_add_u32 v113, 0x80, v96
    s_nop 0
    v_add_u32 v114, 0x80, v100
    s_nop 0
    v_add_u32 v115, 0x80, v104
    v_and_or_b32 v112, v112, v12, s48
    v_and_or_b32 v113, v113, v12, s49
    v_and_or_b32 v114, v114, v12, s50
    v_and_or_b32 v115, v115, v12, s51
    s_mov_b32 exec_hi, 0
    buffer_store_dwordx4 v[112:115], v111, s[44:47], s71 offen
    s_mov_b64 exec, -1
    s_cmp_eq_u32 s3, 1
    s_cbranch_scc0 L_b_h
    s_lshl_b32 s56, s4, 14
    s_lshr_b32 s57, s5, 4
    s_lshl_b32 s57, s57, 13
    s_add_u32 s56, s56, s57
    s_add_u32 s56, s56, 65536
    s_add_u32 s57, s56, 4096
    v_lshrrev_b32 v3, 1, v1
    v_mul_u32_u24 v3, 320, v3
    v_and_b32 v4, 1, v1
    v_lshl_add_u32 v3, v4, 7, v3
    v_lshl_add_u32 v3, v2, 1, v3
    v_add_u32 v3, 131072, v3
    v_mov_b32 v6, 2
    buffer_load_dwordx4 v[64:67], v13, s[44:47], s56 offen offset:0 sc1
    buffer_load_dwordx4 v[68:71], v13, s[44:47], s56 offen offset:1024 sc1
    buffer_load_dwordx4 v[72:75], v13, s[44:47], s56 offen offset:2048 sc1
    buffer_load_dwordx4 v[76:79], v13, s[44:47], s56 offen offset:3072 sc1
    buffer_load_dwordx4 v[80:83], v13, s[44:47], s57 offen offset:0 sc1
    buffer_load_dwordx4 v[84:87], v13, s[44:47], s57 offen offset:1024 sc1
    buffer_load_dwordx4 v[88:91], v13, s[44:47], s57 offen offset:2048 sc1
    buffer_load_dwordx4 v[92:95], v13, s[44:47], s57 offen offset:3072 sc1
    s_branch L_sp24b
L_sp24:
    s_add_u32 s68, s68, 1
    s_cmp_gt_u32 s68, 4194304
    s_cbranch_scc1 L_abort
    s_sleep 1
L_sp24b:
    ds_read_b32 v5, v14 offset:32
    s_waitcnt lgkmcnt(0)
    v_cmp_gt_i32 vcc, 8, v5
    s_cbranch_vccnz L_sp24
    buffer_load_dwordx4 v[32:35], v13, s[44:47], s56 offen offset:0 sc1
    buffer_load_dwordx4 v[36:39], v13, s[44:47], s56 offen offset:1024 sc1
    buffer_load_dwordx4 v[40:43], v13, s[44:47], s56 offen offset:2048 sc1
    buffer_load_dwordx4 v[44:47], v13, s[44:47], s56 offen offset:3072 sc1
    buffer_load_dwordx4 v[48:51], v13, s[44:47], s57 offen offset:0 sc1
    buffer_load_dwordx4 v[52:55], v13, s[44:47], s57 offen offset:1024 sc1
    buffer_load_dwordx4 v[56:59], v13, s[44:47], s57 offen offset:2048 sc1
    buffer_load_dwordx4 v[60:63], v13, s[44:47], s57 offen offset:3072 sc1
    s_waitcnt vmcnt(8)
    v_xor_b32 v64, s48, v64
    v_xor_b32 v65, s49, v65
    v_xor_b32 v66, s50, v66
    v_xor_b32 v67, s51, v67
    v_or3_b32 v4, v64, v65, v66
    v_or_b32 v4, v4, v67
    v_xor_b32 v68, s48, v68
    v_xor_b32 v69, s49, v69
    v_xor_b32 v70, s50, v70
    v_xor_b32 v71, s51, v71
    v_or3_b32 v4, v4, v68, v69
    v_or3_b32 v4, v4, v70, v71
    v_xor_b32 v72, s48, v72
    v_xor_b32 v73, s49, v73
    v_xor_b32 v74, s50, v74
    v_xor_b32 v75, s51, v75
    v_or3_b32 v4, v4, v72, v73
    v_or3_b32 v4, v4, v74, v75
    v_xor_b32 v76, s48, v76
    v_xor_b32 v77, s49, v77
    v_xor_b32 v78, s50, v78
    v_xor_b32 v79, s51, v79
    v_or3_b32 v4, v4, v76, v77
    v_or3_b32 v4, v4, v78, v79
    v_xor_b32 v80, s48, v80
    v_xor_b32 v81, s49, v81
    v_xor_b32 v82, s50, v82
    v_xor_b32 v83, s51, v83
    v_or3_b32 v4, v4, v80, v81
    v_or3_b32 v4, v4, v82, v83
    v_xor_b32 v84, s48, v84
    v_xor_b32 v85, s49, v85
    v_xor_b32 v86, s50, v86
    v_xor_b32 v87, s51, v87
    v_or3_b32 v4, v4, v84, v85
    v_or3_b32 v4, v4, v86, v87
    v_xor_b32 v88, s48, v88
    v_xor_b32 v89, s49, v89
    v_xor_b32 v90, s50, v90
    v_xor_b32 v91, s51, v91
    v_or3_b32 v4, v4, v88, v89
    v_or3_b32 v4, v4, v90, v91
    v_xor_b32 v92, s48, v92
    v_xor_b32 v93, s49, v93
    v_xor_b32 v94, s50, v94
    v_xor_b32 v95, s51, v95
    v_or3_b32 v4, v4, v92, v93
    v_or3_b32 v4, v4, v94, v95
    v_and_b32 v4, 0xff, v4
    v_cmp_ne_u32 vcc, 0, v4
    s_cbranch_vccnz L_a_chk
    v_pk_add_f32 v[64:65], v[64:65], v[72:73]
    v_pk_add_f32 v[80:81], v[80:81], v[88:89]
    v_pk_add_f32 v[66:67], v[66:67], v[74:75]
    v_pk_add_f32 v[82:83], v[82:83], v[90:91]
    v_pk_add_f32 v[68:69], v[68:69], v[76:77]
    v_pk_add_f32 v[84:85], v[84:85], v[92:93]
    v_pk_add_f32 v[70:71], v[70:71], v[78:79]
    v_pk_add_f32 v[86:87], v[86:87], v[94:95]
    v_pk_add_f32 v[16:17], v[64:65], v[80:81]
    v_pk_add_f32 v[18:19], v[66:67], v[82:83]
    v_pk_add_f32 v[20:21], v[68:69], v[84:85]
    v_pk_add_f32 v[22:23], v[70:71], v[86:87]
    s_branch L_a_got
L_a_poll:
    s_add_u32 s68, s68, 1
    s_cmp_gt_u32 s68, 4194304
    s_cbranch_scc1 L_abort
    buffer_load_dwordx4 v[32:35], v13, s[44:47], s56 offen offset:0 sc1
    buffer_load_dwordx4 v[36:39], v13, s[44:47], s56 offen offset:1024 sc1
    buffer_load_dwordx4 v[40:43], v13, s[44:47], s56 offen offset:2048 sc1
    buffer_load_dwordx4 v[44:47], v13, s[44:47], s56 offen offset:3072 sc1
    buffer_load_dwordx4 v[48:51], v13, s[44:47], s57 offen offset:0 sc1
    buffer_load_dwordx4 v[52:55], v13, s[44:47], s57 offen offset:1024 sc1
    buffer_load_dwordx4 v[56:59], v13, s[44:47], s57 offen offset:2048 sc1
    buffer_load_dwordx4 v[60:63], v13, s[44:47], s57 offen offset:3072 sc1
L_a_chk:
    s_waitcnt vmcnt(0)
    v_xor_b32 v32, s48, v32
    v_xor_b32 v33, s49, v33
    v_xor_b32 v34, s50, v34
    v_xor_b32 v35, s51, v35
    v_or3_b32 v4, v32, v33, v34
    v_or_b32 v4, v4, v35
    v_xor_b32 v36, s48, v36
    v_xor_b32 v37, s49, v37
    v_xor_b32 v38, s50, v38
    v_xor_b32 v39, s51, v39
    v_or3_b32 v4, v4, v36, v37
    v_or3_b32 v4, v4, v38, v39
    v_xor_b32 v40, s48, v40
    v_xor_b32 v41, s49, v41
    v_xor_b32 v42, s50, v42
    v_xor_b32 v43, s51, v43
    v_or3_b32 v4, v4, v40, v41
    v_or3_b32 v4, v4, v42, v43
    v_xor_b32 v44, s48, v44
    v_xor_b32 v45, s49, v45
    v_xor_b32 v46, s50, v46
    v_xor_b32 v47, s51, v47
    v_or3_b32 v4, v4, v44, v45
    v_or3_b32 v4, v4, v46, v47
    v_xor_b32 v48, s48, v48
    v_xor_b32 v49, s49, v49
    v_xor_b32 v50, s50, v50
    v_xor_b32 v51, s51, v51
    v_or3_b32 v4, v4, v48, v49
    v_or3_b32 v4, v4, v50, v51
    v_xor_b32 v52, s48, v52
    v_xor_b32 v53, s49, v53
    v_xor_b32 v54, s50, v54
    v_xor_b32 v55, s51, v55
    v_or3_b32 v4, v4, v52, v53
    v_or3_b32 v4, v4, v54, v55
    v_xor_b32 v56, s48, v56
    v_xor_b32 v57, s49, v57
    v_xor_b32 v58, s50, v58
    v_xor_b32 v59, s51, v59
    v_or3_b32 v4, v4, v56, v57
    v_or3_b32 v4, v4, v58, v59
    v_xor_b32 v60, s48, v60
    v_xor_b32 v61, s49, v61
    v_xor_b32 v62, s50, v62
    v_xor_b32 v63, s51, v63
    v_or3_b32 v4, v4, v60, v61
    v_or3_b32 v4, v4, v62, v63
    v_and_b32 v4, 0xff, v4
    v_cmp_ne_u32 vcc, 0, v4
    s_cbranch_vccnz L_a_slow
L_a_ok:
    v_pk_add_f32 v[32:33], v[32:33], v[40:41]
    v_pk_add_f32 v[48:49], v[48:49], v[56:57]
    v_pk_add_f32 v[34:35], v[34:35], v[42:43]
    v_pk_add_f32 v[50:51], v[50:51], v[58:59]
    v_pk_add_f32 v[36:37], v[36:37], v[44:45]
    v_pk_add_f32 v[52:53], v[52:53], v[60:61]
    v_pk_add_f32 v[38:39], v[38:39], v[46:47]
    v_pk_add_f32 v[54:55], v[54:55], v[62:63]
    v_pk_add_f32 v[16:17], v[32:33], v[48:49]
    v_pk_add_f32 v[18:19], v[34:35], v[50:51]
    v_pk_add_f32 v[20:21], v[36:37], v[52:53]
    v_pk_add_f32 v[22:23], v[38:39], v[54:55]
L_a_got:
    v_cvt_pk_bf16_f32 v16, v16, v17
    ds_write_b16 v3, v16 offset:0
    ds_write_b16_d16_hi v3, v16 offset:32
    v_cvt_pk_bf16_f32 v18, v18, v19
    ds_write_b16 v3, v18 offset:64
    ds_write_b16_d16_hi v3, v18 offset:96
    v_cvt_pk_bf16_f32 v20, v20, v21
    ds_write_b16 v3, v20 offset:640
    ds_write_b16_d16_hi v3, v20 offset:672
    v_cvt_pk_bf16_f32 v22, v22, v23
    ds_write_b16 v3, v22 offset:704
    ds_write_b16_d16_hi v3, v22 offset:736
    v_mov_b32 v7, s52
    ds_write_b64 v14, v[6:7] offset:64
    s_waitcnt lgkmcnt(0)
    s_branch L_a_cal
.p2align 12
L_c_main:
    s_sub_u32 s3, s3, 11
    s_mov_b64 s[64:65], s[28:29]
    s_mov_b32 s66, 2048
    s_lshl_b32 s55, s53, 2
    s_add_u32 s55, s55, s3
    s_lshl_b32 s61, s4, 11
    s_add_u32 s61, s61, 327680
    s_lshl_b32 s62, s4, 16
    s_lshl_b32 s60, s55, 11
    s_add_u32 s62, s62, s60
    s_add_u32 s62, s62, 393216
    v_lshlrev_b32 v3, 7, v0
    s_sub_u32 s60, s61, 2048
    v_mov_b32 v4, s62
    v_mov_b32 v5, s60
    v_cmp_gt_u32 vcc, 16, v0
    s_nop 1
    v_cndmask_b32 v4, v5, v4, vcc
    v_add_u32 v3, v3, v4
    s_mov_b32 exec_hi, 0
    buffer_load_dword v122, v3, s[44:47], 0 offen sc1
    s_mov_b64 exec, -1
    s_lshr_b32 s60, s53, 1
    s_lshl_b32 s60, s60, 4
    s_add_u32 s61, s61, s60
    v_and_b32 v12, 1, v0
    v_lshlrev_b32 v12, 4, v12
    v_mov_b32 v13, 0xffff
    v_lshlrev_b32 v12, v12, v13
    v_bfe_u32 v13, v0, 1, 2
    v_cmp_eq_u32 vcc, 0, v13
    s_nop 1
    v_cndmask_b32 v8, 0, v12, vcc
    v_cmp_eq_u32 vcc, 1, v13
    s_nop 1
    v_cndmask_b32 v9, 0, v12, vcc
    v_cmp_eq_u32 vcc, 2, v13
    s_nop 1
    v_cndmask_b32 v10, 0, v12, vcc
    v_cmp_eq_u32 vcc, 3, v13
    s_nop 1
    v_cndmask_b32 v11, 0, v12, vcc
    v_lshrrev_b32 v4, 3, v0
    v_and_b32 v5, 7, v0
    v_bfe_u32 v12, v0, 3, 1
    v_and_b32 v13, 1, v1
    v_lshlrev_b32 v6, 6, v5
    v_lshl_add_u32 v6, v13, 9, v6
    v_lshl_add_u32 v6, v12, 10, v6
    v_lshlrev_b32 v126, 14, v4
    v_lshl_add_u32 v126, v5, 4, v126
    s_lshl_b32 s60, s3, 6
    s_add_u32 s60, s60, 134912
    v_lshlrev_b32 v3, 5, v12
    v_lshl_add_u32 v3, v1, 3, v3
    v_add_u32 v3, s60, v3
    v_lshl_add_u32 v72, v12, 2, v14
    v_mov_b32 v124, 0xfffff000
    v_lshlrev_b32 v4, 4, v0
    v_lshlrev_b32 v125, 7, v0
    s_lshl_b32 s63, s3, 10
    v_add_u32 v98, s63, v4
    v_add_u32 v13, 135168, v98
    v_xor_b32 v7, 0x400, v13
    v_xor_b32 v12, 0x800, v13
    v_xor_b32 v99, 0xc00, v13
    v_and_b32 v2, 1, v1
    v_lshlrev_b32 v2, 2, v2
    v_and_b32 v1, 2, v1
    v_add_u32 v2, v2, v1
    s_lshl_b32 s59, s4, 3
    s_add_u32 s59, s59, s53
    s_lshl_b32 s58, s54, 17
    s_add_u32 s58, s58, 1048576
    s_lshl_b32 s57, s59, 7
    s_add_u32 s57, s57, s58
    s_lshl_b32 s60, s4, 14
    s_add_u32 s58, s58, s60
    s_lshl_b32 s60, s53, 4
    s_add_u32 s58, s58, s60
    s_lshr_b32 s60, s59, 5
    s_lshl_b32 s60, s60, 10
    s_lshl_b32 s63, s54, 8
    s_add_u32 s60, s60, s63
    s_and_b32 s63, s59, 15
    s_lshl_b32 s63, s63, 4
    s_add_u32 s60, s60, s63
    s_bfe_u32 s63, s59, 0x10004
    s_lshl_b32 s63, s63, 3
    s_add_u32 s60, s60, s63
    s_add_u32 s56, s57, 8192
    s_add_u32 s55, s58, 8192
    s_branch L_sp25b
L_sp25:
    s_add_u32 s68, s68, 1
    s_cmp_gt_u32 s68, 4194304
    s_cbranch_scc1 L_abort
    s_sleep 8
L_sp25b:
    ds_read_b32 v127, v14 offset:56
    ds_read_b32 v123, v72 offset:72
    s_waitcnt lgkmcnt(0)
    v_cmp_gt_i32 vcc, 1, v127
    s_cbranch_vccnz L_sp25
    v_mov_b32 v112, 0
    v_mov_b32 v113, 0
    s_cmp_ge_u32 s5, s34
    s_cbranch_scc1 L_c_noh
    s_branch L_sp26b
L_sp26:
    s_add_u32 s68, s68, 1
    s_cmp_gt_u32 s68, 4194304
    s_cbranch_scc1 L_abort
    s_sleep 4
L_sp26b:
    ds_read_b32 v127, v14 offset:52
    ds_read_b64 v[112:113], v3
    s_waitcnt lgkmcnt(0)
    v_cmp_gt_i32 vcc, 1, v127
    s_cbranch_vccnz L_sp26
L_c_noh:
    v_and_b32 v40, v112, v8
    v_and_b32 v41, v112, v9
    v_and_b32 v42, v112, v10
    v_and_b32 v43, v112, v11
    v_and_b32 v44, v113, v8
    v_and_b32 v45, v113, v9
    v_and_b32 v46, v113, v10
    v_and_b32 v47, v113, v11
    s_branch L_sp27b
L_sp27:
    s_add_u32 s68, s68, 1
    s_cmp_gt_u32 s68, 4194304
    s_cbranch_scc1 L_abort
    s_sleep 4
L_sp27b:
    ds_read_b32 v127, v14 offset:40
    ds_read_b32 v97, v14 offset:68
    s_waitcnt lgkmcnt(0)
    v_cmp_gt_i32 vcc, 8, v127
    s_cbranch_vccnz L_sp27
    v_readfirstlane_b32 s52, v97
    s_nop 0
    s_and_b32 s48, s52, 0xfff
    s_bfe_u32 s49, s52, 0xc0008
    s_bfe_u32 s50, s52, 0xc0010
    s_and_b32 s51, s52, 15
    s_lshl_b32 s51, s51, 8
    s_lshr_b32 s35, s52, 24
    s_or_b32 s51, s51, s35
    s_setprio 3
    s_branch L_sp28b
L_sp28:
    s_add_u32 s68, s68, 1
    s_cmp_gt_u32 s68, 4194304
    s_cbranch_scc1 L_abort
L_sp28b:
    ds_read_b32 v127, v14 offset:48
    ds_read_b32 v114, v14 offset:32
    s_waitcnt lgkmcnt(0)
    v_cmp_gt_i32 vcc, 8, v127
    s_cbranch_vccnz L_sp28
    s_branch L_sp29c
L_sp29:
    s_add_u32 s68, s68, 1
    s_cmp_gt_u32 s68, 4194304
    s_cbranch_scc1 L_abort
L_sp29b:
    ds_read_b32 v114, v14 offset:32
    s_waitcnt lgkmcnt(0)
L_sp29c:
    v_cmp_gt_i32 vcc, 43, v114
    s_cbranch_vccnz L_sp29
    buffer_load_dwordx4 v[64:67], v4, s[44:47], s62 offen offset:0 sc1
    buffer_load_dwordx4 v[68:71], v4, s[44:47], s62 offen offset:1024 sc1
    buffer_load_dwordx4 v[72:75], v6, s[44:47], s61 offen sc1
    ds_read_b128 v[32:35], v98 offset:16384
    ds_read_b128 v[36:39], v98 offset:20480
    ds_read_b128 v[16:19], v98 offset:24576
    s_waitcnt lgkmcnt(2)
    v_mfma_f32_16x16x32_bf16 v[100:103], v[40:43], v[32:35], 0
    s_waitcnt lgkmcnt(1)
    v_mfma_f32_16x16x32_bf16 v[100:103], v[44:47], v[36:39], v[100:103]
    s_waitcnt vmcnt(2)
    v_xor_b32 v64, s48, v64
    v_xor_b32 v65, s49, v65
    v_xor_b32 v66, s50, v66
    v_xor_b32 v67, s51, v67
    v_or3_b32 v5, v64, v65, v66
    v_or_b32 v5, v5, v67
    s_waitcnt vmcnt(1)
    v_xor_b32 v68, s48, v68
    v_xor_b32 v69, s49, v69
    v_xor_b32 v70, s50, v70
    v_xor_b32 v71, s51, v71
    v_or3_b32 v5, v5, v68, v69
    v_or3_b32 v5, v5, v70, v71
    v_and_b32 v5, 0xfff, v5
    v_cmp_ne_u32 vcc, 0, v5
    s_waitcnt vmcnt(0)
    s_mov_b64 s[70:71], vcc
    s_cbranch_vccz L_c_schk
    s_mov_b64 exec, vcc
    buffer_load_dwordx4 v[64:67], v4, s[44:47], s62 offen offset:0 sc1
    buffer_load_dwordx4 v[68:71], v4, s[44:47], s62 offen offset:1024 sc1
    s_mov_b64 exec, -1
    s_branch L_c_schk
L_c_late:
    s_branch L_sp30b
L_sp30:
    s_add_u32 s68, s68, 1
    s_cmp_gt_u32 s68, 4194304
    s_cbranch_scc1 L_abort
L_sp30b:
    ds_read_b32 v127, v14 offset:32
    s_waitcnt lgkmcnt(0)
    v_cmp_gt_i32 vcc, 46, v127
    s_cbranch_vccnz L_sp30
    ds_read_b128 v[20:23], v98 offset:28672
    ds_read_b128 v[24:27], v98 offset:32768
    ds_read_b128 v[28:31], v98 offset:36864
    s_waitcnt lgkmcnt(0)
    s_branch L_c_mm
L_c_stat:
    s_add_u32 s68, s68, 1
    s_cmp_gt_u32 s68, 4194304
    s_cbranch_scc1 L_abort
    s_sleep 2
    buffer_load_dwordx4 v[72:75], v6, s[44:47], s61 offen sc1
    s_waitcnt vmcnt(0)
L_c_schk:
    v_xor_b32 v72, s48, v72
    v_xor_b32 v73, s49, v73
    v_xor_b32 v74, s50, v74
    v_xor_b32 v75, s51, v75
    v_or3_b32 v76, v72, v73, v74
    v_or_b32 v76, v76, v75
    v_max_f32_dpp v96, v72, v72 quad_perm:[1,0,3,2] row_mask:0xf bank_mask:0xf
    v_and_b32 v76, 0xfff, v76
    v_cmp_ne_u32 vcc, 0, v76
    s_cbranch_vccnz L_c_stat
    v_max_f32_dpp v96, v96, v96 quad_perm:[2,3,0,1] row_mask:0xf bank_mask:0xf
    ds_read_b32 v127, v14 offset:32
    ds_read_b128 v[20:23], v98 offset:28672
    v_max_f32_dpp v96, v96, v96 row_half_mirror row_mask:0xf bank_mask:0xf
    v_mov_b32 v97, v96
    ds_read_b128 v[24:27], v98 offset:32768
    ds_read_b128 v[28:31], v98 offset:36864
    v_permlane16_swap_b32 v96, v97
    v_max_f32 v96, v96, v97
    v_sub_f32 v96, v72, v96
    v_mul_f32 v96, 0x3fb8aa3b, v96
    v_exp_f32 v96, v96
    s_nop 0
    v_mul_f32 v112, v96, v73
    v_mul_f32 v96, v96, v123
    v_mov_b32 v97, v96
    v_add_f32_dpp v112, v112, v112 quad_perm:[1,0,3,2] row_mask:0xf bank_mask:0xf
    s_cmp_eq_u64 s[70:71], 0
    v_permlane16_swap_b32 v96, v97
    v_add_f32_dpp v112, v112, v112 quad_perm:[2,3,0,1] row_mask:0xf bank_mask:0xf
    s_cbranch_scc1 L_c_ook
    s_mov_b64 exec, s[70:71]
    s_branch L_c_oloop
L_c_oy:
    s_mov_b64 exec, vcc
    s_add_u32 s68, s68, 1
    s_cmp_gt_u32 s68, 4194304
    s_cbranch_scc1 L_abort
    buffer_load_dwordx4 v[64:67], v4, s[44:47], s62 offen offset:0 sc1
    buffer_load_dwordx4 v[68:71], v4, s[44:47], s62 offen offset:1024 sc1
L_c_oloop:
    s_waitcnt vmcnt(1)
    v_xor_b32 v64, s48, v64
    v_xor_b32 v65, s49, v65
    v_xor_b32 v66, s50, v66
    v_xor_b32 v67, s51, v67
    v_or3_b32 v5, v64, v65, v66
    v_or_b32 v5, v5, v67
    s_waitcnt vmcnt(0)
    v_xor_b32 v68, s48, v68
    v_xor_b32 v69, s49, v69
    v_xor_b32 v70, s50, v70
    v_xor_b32 v71, s51, v71
    v_or3_b32 v5, v5, v68, v69
    v_or3_b32 v5, v5, v70, v71
    v_and_b32 v5, 0xfff, v5
    v_cmp_ne_u32 vcc, 0, v5
    s_cbranch_vccnz L_c_oy
L_c_ook:
    s_mov_b64 exec, 1
    ds_add_u32 v14, v15 offset:104
    s_mov_b64 exec, -1
    v_mul_f32 v104, v96, v64
    v_mul_f32 v105, v96, v65
    v_add_f32_dpp v112, v112, v112 row_half_mirror row_mask:0xf bank_mask:0xf
    v_mul_f32 v106, v96, v66
    v_mul_f32 v107, v96, v67
    v_mov_b32 v113, v112
    v_fmac_f32 v104, v97, v68
    v_fmac_f32 v105, v97, v69
    v_fmac_f32 v106, v97, v70
    v_fmac_f32 v107, v97, v71
    v_permlane16_swap_b32 v112, v113
    v_add_f32_dpp v104, v104, v104 quad_perm:[1,0,3,2] row_mask:0xf bank_mask:0xf
    v_add_f32_dpp v105, v105, v105 quad_perm:[1,0,3,2] row_mask:0xf bank_mask:0xf
    v_add_f32_dpp v106, v106, v106 quad_perm:[1,0,3,2] row_mask:0xf bank_mask:0xf
    v_add_f32_dpp v107, v107, v107 quad_perm:[1,0,3,2] row_mask:0xf bank_mask:0xf
    v_add_f32 v112, v112, v113
    v_add_f32_dpp v104, v104, v104 quad_perm:[2,3,0,1] row_mask:0xf bank_mask:0xf
    v_add_f32_dpp v105, v105, v105 quad_perm:[2,3,0,1] row_mask:0xf bank_mask:0xf
    v_add_f32_dpp v106, v106, v106 quad_perm:[2,3,0,1] row_mask:0xf bank_mask:0xf
    v_add_f32_dpp v107, v107, v107 quad_perm:[2,3,0,1] row_mask:0xf bank_mask:0xf
    v_rcp_f32 v112, v112
    v_add_f32_dpp v104, v104, v104 row_half_mirror row_mask:0xf bank_mask:0xf
    v_add_f32_dpp v105, v105, v105 row_half_mirror row_mask:0xf bank_mask:0xf
    v_add_f32_dpp v106, v106, v106 row_half_mirror row_mask:0xf bank_mask:0xf
    v_add_f32_dpp v107, v107, v107 row_half_mirror row_mask:0xf bank_mask:0xf
    v_mul_f32 v104, v104, v112
    v_mul_f32 v105, v105, v112
    v_mul_f32 v106, v106, v112
    v_mul_f32 v107, v107, v112
    v_cvt_pk_bf16_f32 v104, v104, v104
    v_cvt_pk_bf16_f32 v105, v105, v105
    v_cvt_pk_bf16_f32 v106, v106, v106
    v_cvt_pk_bf16_f32 v107, v107, v107
    v_and_b32 v116, v104, v8
    v_and_b32 v117, v104, v9
    v_and_b32 v118, v104, v10
    v_and_b32 v119, v104, v11
    s_waitcnt lgkmcnt(1)
    v_cmp_gt_i32 vcc, 46, v127
    s_cbranch_vccnz L_c_late
L_c_mm:
    v_and_b32 v120, v105, v8
    v_and_b32 v121, v105, v9
    v_and_b32 v122, v105, v10
    v_and_b32 v123, v105, v11
    v_mfma_f32_16x16x32_bf16 v[100:103], v[116:119], v[16:19], v[100:103]
    v_and_b32 v116, v106, v8
    v_and_b32 v117, v106, v9
    v_and_b32 v118, v106, v10
    v_and_b32 v119, v106, v11
    v_mfma_f32_16x16x32_bf16 v[100:103], v[120:123], v[20:23], v[100:103]
    v_and_b32 v120, v107, v8
    v_and_b32 v121, v107, v9
    v_and_b32 v122, v107, v10
    v_and_b32 v123, v107, v11
    v_mfma_f32_16x16x32_bf16 v[100:103], v[116:119], v[24:27], v[100:103]
    s_nop 0
    v_mfma_f32_16x16x32_bf16 v[100:103], v[120:123], v[28:31], v[100:103]
    s_nop 7
    ds_write_b128 v13, v[100:103]
    s_mov_b64 exec, 1
    ds_add_rtn_u32 v127, v14, v15 offset:60
    s_mov_b64 exec, -1
    ds_read_b128 v[104:107], v7
    ds_read_b128 v[108:111], v12
    ds_read_b128 v[112:115], v99
    s_waitcnt lgkmcnt(2)
    v_readfirstlane_b32 s63, v127
    v_pk_add_f32 v[104:105], v[104:105], v[100:101]
    v_pk_add_f32 v[106:107], v[106:107], v[102:103]
    s_cmp_eq_u32 s63, 3
    s_cbranch_scc0 L_c_end
    s_waitcnt lgkmcnt(0)
    v_pk_add_f32 v[108:109], v[108:109], v[112:113]
    v_pk_add_f32 v[110:111], v[110:111], v[114:115]
    v_pk_add_f32 v[104:105], v[104:105], v[108:109]
    v_pk_add_f32 v[106:107], v[106:107], v[110:111]
    v_and_or_b32 v104, v104, v124, s48
    v_and_or_b32 v105, v105, v124, s49
    v_and_or_b32 v106, v106, v124, s50
    v_and_or_b32 v107, v107, v124, s51
    buffer_store_dwordx4 v[104:107], v126, s[44:47], s57 offen sc1
    buffer_store_dwordx4 v[104:107], v126, s[44:47], s56 offen sc1
    s_branch L_sp31b
L_sp31:
    s_add_u32 s68, s68, 1
    s_cmp_gt_u32 s68, 4194304
    s_cbranch_scc1 L_abort
    s_sleep 1
L_sp31b:
    ds_read_b32 v108, v14 offset:108
    s_waitcnt lgkmcnt(0)
    v_cmp_gt_i32 vcc, 1, v108
    s_cbranch_vccnz L_sp31
    v_cmp_eq_u32 vcc, 1, v108
    s_nop 0
    s_cmp_lg_u64 vcc, 0
    s_cselect_b32 s58, s58, s55
    s_waitcnt vmcnt(0)
    s_branch L_c_fp1
L_c_fpoll:
    s_mov_b64 exec, vcc
    s_add_u32 s68, s68, 1
    s_cmp_gt_u32 s68, 4194304
    s_cbranch_scc1 L_abort
L_c_fp1:
    buffer_load_dwordx4 v[64:67], v125, s[44:47], s58 offen sc1
    s_waitcnt vmcnt(0)
    v_xor_b32 v64, s48, v64
    v_xor_b32 v65, s49, v65
    v_xor_b32 v66, s50, v66
    v_xor_b32 v67, s51, v67
    v_or3_b32 v5, v64, v65, v66
    v_or_b32 v5, v5, v67
    v_and_b32 v5, 0xfff, v5
    v_cmp_ne_u32 vcc, 0, v5
    s_cbranch_vccnz L_c_fpoll
    s_mov_b64 exec, -1
    v_permlane32_swap_b32 v64, v65
    v_permlane32_swap_b32 v66, v67
    v_add_f32 v64, v64, v65
    v_add_f32 v66, v66, v67
    s_nop 1
    v_permlane16_swap_b32 v64, v66
    v_add_f32 v64, v64, v66
    s_nop 1
    v_add_f32_dpp v64, v64, v64 row_ror:8 row_mask:0xf bank_mask:0xf
    s_nop 1
    v_add_f32_dpp v64, v64, v64 row_ror:4 row_mask:0xf bank_mask:0xf
    s_nop 1
    v_add_f32_dpp v64, v64, v64 row_ror:2 row_mask:0xf bank_mask:0xf
    s_nop 1
    v_add_f32_dpp v64, v64, v64 row_ror:1 row_mask:0xf bank_mask:0xf
    v_cvt_pk_bf16_f32 v64, v64, v64
    s_mov_b32 exec_lo, 0x00010001
    s_mov_b32 exec_hi, 0x00010001
    buffer_store_short v64, v2, s[64:67], s60 offen
    s_cmp_eq_u32 s2, 0
    s_cbranch_scc0 L_c_end
    s_mov_b64 exec, 1
    v_mov_b32 v4, s52
    v_mov_b32 v5, 0
    buffer_store_dword v4, v5, s[44:47], 0 offen
L_c_end:
L_abort:
    s_endpgm
.section .rodata,"a"
.p2align 6
.amdhsa_kernel gated_mix__sliding_block_cached__swiglu_ffn__decode_kernel
  .amdhsa_next_free_vgpr 128
  .amdhsa_next_free_sgpr 102
  .amdhsa_accum_offset 128
  .amdhsa_group_segment_fixed_size 0
  .amdhsa_kernarg_size 104
  .amdhsa_user_sgpr_count 2
  .amdhsa_user_sgpr_kernarg_segment_ptr 1
  .amdhsa_system_sgpr_workgroup_id_x 1
.end_amdhsa_kernel
```
